```python
import torch

def _softmax(x, axis=-1):
    return torch.softmax(x, dim=axis)

def _gelu(x):
    return torch.nn.functional.gelu(x, approximate='tanh')

def _silu(x):
    return torch.nn.functional.silu(x)

def _sigmoid(x):
    return torch.sigmoid(x)

def _layernorm(x, axis=-1, eps=1e-05):
    m = x.mean(dim=axis, keepdim=True)
    v = x.var(dim=axis, keepdim=True, unbiased=False)
    return (x - m) / torch.sqrt(v + eps)

def _scatter_add(tgt, idx, src, axis=0):
    return tgt.clone().index_add_(axis, idx, src)

def _segment_sum(src, seg, n):
    out = torch.zeros((n,) + src.shape[1:], dtype=src.dtype)
    return out.index_add_(0, seg, src)

def _pad(x, pw):
    flat = tuple((v for pair in reversed(pw) for v in pair))
    return torch.nn.functional.pad(x, flat)
kernel_name = 'standalone__molecular_angular_painn__graph'

def setup_inputs():

    _w = lambda a: (lambda t: t.to(torch.bfloat16) if t.is_floating_point() else t)(torch.as_tensor(a))
    N, deg, D = (25000, 16, 128)
    n_rbf = max(16, 4)
    E = N * deg
    cutoff = 5.0
    freqs = (torch.arange(1, n_rbf + 1) * torch.pi / cutoff).to(float)
    return {'sv': _w((lambda *s: torch.randn(*s, dtype=torch.bfloat16) * 0.4)(N, 4, D) * 0.3), 'pos': _w((lambda *s: torch.randn(*s, dtype=torch.bfloat16) * 3.2)(N, 3) * 1.2), 'src': _w((lambda lo, hi, *s: torch.randint(lo, hi, s))(0, N, E).to(torch.int64)), 'dst': _w((lambda lo, hi, *s: torch.randint(lo, hi, s))(0, N, E).to(torch.int64)), 'freqs': _w(freqs), 'w_phi1': _w((lambda *s: torch.randn(*s, dtype=torch.bfloat16) * 3.2)(D, D) / D ** 0.5), 'w_phi2': _w((lambda *s: torch.randn(*s, dtype=torch.bfloat16) * 3.2)(D, 3 * D) / D ** 0.5), 'w_rbf': _w((lambda *s: torch.randn(*s, dtype=torch.bfloat16) * 3.2)(n_rbf, 3 * D) / n_rbf ** 0.5)}

def reference(sv, pos, src, dst, freqs, w_phi1, w_phi2, w_rbf):
    N, _, D = sv.shape
    E = src.shape[0]
    PI, cutoff = (3.141592653589793, 5.0)
    s, v = (sv[:, 0, :].clone(), sv[:, 1:, :].clone())
    r_vec = pos[src] - pos[dst]
    d = torch.sqrt((r_vec * r_vec).sum(-1) + 1e-08)
    r_hat = r_vec / d[:, None]
    rbf = torch.sin(d[:, None] * freqs[None, :]) / d[:, None]
    fcut = 0.5 * (torch.cos(PI * d / cutoff) + 1.0)
    fcut = torch.where(d < cutoff, fcut, 0.0 * d)
    Wf = rbf @ w_rbf * fcut[:, None]
    phi = (_silu(s @ w_phi1) @ w_phi2)[src]
    m = phi * Wf
    m_s, m_vv, m_vr = (m[:, :D].clone(), m[:, D:2 * D].clone(), m[:, 2 * D:].clone())
    ds = _segment_sum(m_s, dst, N)
    dv_e = m_vv[:, None, :] * v[src] + m_vr[:, None, :] * r_hat[:, :, None]
    dv = _segment_sum(dv_e.reshape(E, 3 * D), dst, N).reshape(N, 3, D)
    return sv + torch.concatenate([ds[:, None, :], dv], axis=1)
```

```asm
; @launch kernel=painn_prep_kernel grid=(242,1,1) block=(256,1,1) lds=0
; @launch kernel=painn_mlp_edge_kernel grid=(1759,1,1) block=(256,1,1) lds=0
; @launch kernel=painn_agg_kernel grid=(1024,1,1) block=(256,1,1) lds=0
.amdgcn_target "amdgcn-amd-amdhsa--gfx950"
.text
.globl painn_prep_kernel
.p2align 8
.type painn_prep_kernel,@function
painn_prep_kernel:
  s_load_dwordx2 s[4:5], s[0:1], 80
  s_load_dwordx2 s[6:7], s[0:1], 40
  s_load_dwordx2 s[8:9], s[0:1], 48
  s_load_dwordx2 s[10:11], s[0:1], 56
  s_waitcnt lgkmcnt(0)
  s_mov_b32 s12, s4
  s_mov_b32 s13, s5
  s_and_b32 s13, s13, 0xffff
  s_mov_b32 s14, 0x80000
  s_mov_b32 s15, 0x00020000
  s_mov_b32 s16, s6
  s_mov_b32 s17, s7
  s_and_b32 s17, s17, 0xffff
  s_mov_b32 s18, 0x8000
  s_mov_b32 s19, 0x00020000
  s_mov_b32 s20, s8
  s_mov_b32 s21, s9
  s_and_b32 s21, s21, 0xffff
  s_mov_b32 s22, 0x18000
  s_mov_b32 s23, 0x00020000
  s_mov_b32 s24, s10
  s_mov_b32 s25, s11
  s_and_b32 s25, s25, 0xffff
  s_mov_b32 s26, 0x3000
  s_mov_b32 s27, 0x00020000
  s_cmp_ge_u32 s2, 98
  s_cbranch_scc1 Lp_w1
  s_lshl_b32 s3, s2, 8
  v_add_u32 v1, s3, v0
  v_mov_b32 v2, -1
  v_cmp_gt_u32 vcc, 25000, v1
  s_and_saveexec_b64 s[40:41], vcc
  s_cbranch_execz Lp_end
  v_lshlrev_b32 v1, 2, v1
  buffer_store_dword v2, v1, s[12:15], 0 offen
  s_branch Lp_end
Lp_w1:
  s_cmp_ge_u32 s2, 130
  s_cbranch_scc1 Lp_w2
  s_sub_u32 s3, s2, 98
  s_lshl_b32 s3, s3, 8
  v_add_u32 v1, s3, v0
  v_and_b32 v2, 3, v1
  v_bfe_u32 v3, v1, 2, 6
  v_bfe_u32 v4, v1, 8, 3
  v_lshrrev_b32 v5, 11, v1
  v_lshrrev_b32 v6, 5, v3
  v_and_b32 v7, 31, v3
  v_lshlrev_b32 v8, 4, v4
  v_lshl_add_u32 v8, v6, 3, v8
  v_lshl_add_u32 v8, v2, 1, v8
  v_lshl_add_u32 v9, v5, 5, v7
  v_lshl_add_u32 v10, v8, 7, v9
  v_lshlrev_b32 v10, 1, v10
  buffer_load_ushort v11, v10, s[16:19], 0 offen
  buffer_load_ushort v12, v10, s[16:19], 0 offen offset:256
  v_lshlrev_b32 v13, 2, v1
  s_waitcnt vmcnt(0)
  v_lshl_or_b32 v11, v12, 16, v11
  v_add_u32 v13, 0x20000, v13
  buffer_store_dword v11, v13, s[12:15], 0 offen
  s_branch Lp_end
Lp_w2:
  s_cmp_ge_u32 s2, 226
  s_cbranch_scc1 Lp_wr
  s_sub_u32 s3, s2, 130
  s_lshl_b32 s3, s3, 8
  v_add_u32 v1, s3, v0
  v_and_b32 v2, 3, v1
  v_bfe_u32 v3, v1, 2, 6
  v_bfe_u32 v4, v1, 8, 1
  v_bfe_u32 v5, v1, 9, 2
  v_lshrrev_b32 v14, 11, v1
  v_lshrrev_b32 v6, 5, v3
  v_and_b32 v7, 31, v3
  v_lshlrev_b32 v8, 5, v5
  v_lshl_add_u32 v8, v4, 4, v8
  v_and_b32 v15, 1, v2
  v_lshl_add_u32 v8, v15, 1, v8
  v_lshrrev_b32 v15, 1, v2
  v_lshl_add_u32 v8, v15, 3, v8
  v_lshl_add_u32 v8, v6, 2, v8
  v_lshl_add_u32 v9, v14, 5, v7
  v_mul_u32_u24 v10, 384, v8
  v_add_lshl_u32 v10, v10, v9, 1
  buffer_load_ushort v11, v10, s[20:23], 0 offen
  buffer_load_ushort v12, v10, s[20:23], 0 offen offset:768
  v_lshlrev_b32 v13, 2, v1
  s_waitcnt vmcnt(0)
  v_lshl_or_b32 v11, v12, 16, v11
  v_add_u32 v13, 0x28000, v13
  buffer_store_dword v11, v13, s[12:15], 0 offen
  s_branch Lp_end
Lp_wr:
  s_cmp_ge_u32 s2, 242
  s_cbranch_scc1 Lp_end
  s_sub_u32 s3, s2, 226
  s_lshl_b32 s3, s3, 8
  v_add_u32 v1, s3, v0
  v_lshrrev_b32 v2, 6, v1
  v_and_b32 v3, 63, v1
  v_cmp_gt_u32 vcc, 48, v3
  s_and_saveexec_b64 s[40:41], vcc
  s_cbranch_execz Lp_end
  v_lshrrev_b32 v4, 4, v3
  v_bfe_u32 v5, v3, 3, 1
  v_and_b32 v6, 7, v3
  v_lshlrev_b32 v7, 7, v4
  v_lshl_add_u32 v7, v2, 1, v7
  v_add_u32 v7, v7, v5
  v_mul_u32_u24 v8, 768, v6
  v_add_lshl_u32 v8, v8, v7, 1
  buffer_load_ushort v11, v8, s[24:27], 0 offen
  buffer_load_ushort v12, v8, s[24:27], 0 offen offset:768
  v_mul_u32_u24 v13, 48, v2
  v_add_lshl_u32 v13, v13, v3, 2
  s_waitcnt vmcnt(0)
  v_lshl_or_b32 v11, v12, 16, v11
  v_add_u32 v13, 0x40000, v13
  buffer_store_dword v11, v13, s[12:15], 0 offen
Lp_end:
  s_endpgm
.globl painn_mlp_edge_kernel
.p2align 8
.type painn_mlp_edge_kernel,@function
painn_mlp_edge_kernel:
  s_load_dwordx2 s[4:5], s[0:1], 80
  s_load_dwordx2 s[6:7], s[0:1], 0
  s_load_dwordx2 s[8:9], s[0:1], 8
  s_load_dwordx2 s[10:11], s[0:1], 16
  s_load_dwordx2 s[12:13], s[0:1], 24
  s_load_dwordx2 s[14:15], s[0:1], 32
  s_cmp_ge_u32 s2, 196
  s_cbranch_scc1 Le_start
  s_waitcnt lgkmcnt(0)
  s_mov_b32 s16, s4
  s_mov_b32 s17, s5
  s_and_b32 s17, s17, 0xffff
  s_mov_b32 s18, 0x80000
  s_mov_b32 s19, 0x00020000
  s_mov_b32 s20, s6
  s_mov_b32 s21, s7
  s_and_b32 s21, s21, 0xffff
  s_mov_b32 s22, 0x186a000
  s_mov_b32 s23, 0x00020000
  s_add_u32 s24, s4, 0x100000
  s_addc_u32 s25, s5, 0
  s_and_b32 s25, s25, 0xffff
  s_mov_b32 s26, 0x124f800
  s_mov_b32 s27, 0x00020000
  v_lshrrev_b32 v1, 6, v0
  v_and_b32 v2, 63, v0
  v_and_b32 v3, 31, v2
  v_lshrrev_b32 v4, 5, v2
  s_lshl_b32 s3, s2, 7
  v_lshl_add_u32 v5, v1, 5, v3
  v_add_u32 v5, s3, v5
  v_lshlrev_b32 v6, 10, v5
  v_lshl_add_u32 v6, v4, 4, v6
  v_mul_u32_u24 v7, 768, v5
  v_lshl_add_u32 v7, v4, 3, v7
  v_lshlrev_b32 v8, 4, v2
  buffer_load_dwordx4 v[16:19], v6, s[20:23], 0 offen offset:0
  buffer_load_dwordx4 v[20:23], v6, s[20:23], 0 offen offset:32
  buffer_load_dwordx4 v[24:27], v6, s[20:23], 0 offen offset:64
  buffer_load_dwordx4 v[28:31], v6, s[20:23], 0 offen offset:96
  buffer_load_dwordx4 v[32:35], v6, s[20:23], 0 offen offset:128
  buffer_load_dwordx4 v[36:39], v6, s[20:23], 0 offen offset:160
  buffer_load_dwordx4 v[40:43], v6, s[20:23], 0 offen offset:192
  buffer_load_dwordx4 v[44:47], v6, s[20:23], 0 offen offset:224
  s_mov_b32 s30, 0x20000
  s_mov_b32 s31, 0x21000
  buffer_load_dwordx4 v[48:51], v8, s[16:19], s30 offen offset:0
  buffer_load_dwordx4 v[52:55], v8, s[16:19], s30 offen offset:1024
  buffer_load_dwordx4 v[56:59], v8, s[16:19], s30 offen offset:2048
  buffer_load_dwordx4 v[60:63], v8, s[16:19], s30 offen offset:3072
  buffer_load_dwordx4 v[64:67], v8, s[16:19], s31 offen offset:0
  buffer_load_dwordx4 v[68:71], v8, s[16:19], s31 offen offset:1024
  buffer_load_dwordx4 v[72:75], v8, s[16:19], s31 offen offset:2048
  buffer_load_dwordx4 v[76:79], v8, s[16:19], s31 offen offset:3072
  s_mov_b32 s30, 0x22000
  s_mov_b32 s31, 0x23000
  buffer_load_dwordx4 v[80:83], v8, s[16:19], s30 offen offset:0
  buffer_load_dwordx4 v[84:87], v8, s[16:19], s30 offen offset:1024
  buffer_load_dwordx4 v[88:91], v8, s[16:19], s30 offen offset:2048
  buffer_load_dwordx4 v[92:95], v8, s[16:19], s30 offen offset:3072
  buffer_load_dwordx4 v[96:99], v8, s[16:19], s31 offen offset:0
  buffer_load_dwordx4 v[100:103], v8, s[16:19], s31 offen offset:1024
  buffer_load_dwordx4 v[104:107], v8, s[16:19], s31 offen offset:2048
  buffer_load_dwordx4 v[108:111], v8, s[16:19], s31 offen offset:3072
  s_waitcnt vmcnt(8)
  v_mfma_f32_32x32x16_bf16 v[112:127], v[48:51], v[16:19], 0
  v_mfma_f32_32x32x16_bf16 v[112:127], v[52:55], v[20:23], v[112:127]
  v_mfma_f32_32x32x16_bf16 v[112:127], v[56:59], v[24:27], v[112:127]
  v_mfma_f32_32x32x16_bf16 v[112:127], v[60:63], v[28:31], v[112:127]
  v_mfma_f32_32x32x16_bf16 v[112:127], v[64:67], v[32:35], v[112:127]
  v_mfma_f32_32x32x16_bf16 v[112:127], v[68:71], v[36:39], v[112:127]
  v_mfma_f32_32x32x16_bf16 v[112:127], v[72:75], v[40:43], v[112:127]
  v_mfma_f32_32x32x16_bf16 v[112:127], v[76:79], v[44:47], v[112:127]
  s_nop 7
  s_nop 3
  v_cvt_pk_bf16_f32 v9, v112, v113
  v_lshlrev_b32 v10, 16, v9
  v_and_b32 v11, 0xffff0000, v9
  v_mul_f32 v12, 0xbfb8aa3b, v10
  v_mul_f32 v13, 0xbfb8aa3b, v11
  v_exp_f32 v12, v12
  v_exp_f32 v13, v13
  s_nop 0
  v_add_f32 v12, 1.0, v12
  v_add_f32 v13, 1.0, v13
  v_rcp_f32 v12, v12
  v_rcp_f32 v13, v13
  s_nop 0
  v_mul_f32 v12, v10, v12
  v_mul_f32 v13, v11, v13
  v_cvt_pk_bf16_f32 v128, v12, v13
  v_cvt_pk_bf16_f32 v9, v114, v115
  v_lshlrev_b32 v10, 16, v9
  v_and_b32 v11, 0xffff0000, v9
  v_mul_f32 v12, 0xbfb8aa3b, v10
  v_mul_f32 v13, 0xbfb8aa3b, v11
  v_exp_f32 v12, v12
  v_exp_f32 v13, v13
  s_nop 0
  v_add_f32 v12, 1.0, v12
  v_add_f32 v13, 1.0, v13
  v_rcp_f32 v12, v12
  v_rcp_f32 v13, v13
  s_nop 0
  v_mul_f32 v12, v10, v12
  v_mul_f32 v13, v11, v13
  v_cvt_pk_bf16_f32 v129, v12, v13
  v_cvt_pk_bf16_f32 v9, v116, v117
  v_lshlrev_b32 v10, 16, v9
  v_and_b32 v11, 0xffff0000, v9
  v_mul_f32 v12, 0xbfb8aa3b, v10
  v_mul_f32 v13, 0xbfb8aa3b, v11
  v_exp_f32 v12, v12
  v_exp_f32 v13, v13
  s_nop 0
  v_add_f32 v12, 1.0, v12
  v_add_f32 v13, 1.0, v13
  v_rcp_f32 v12, v12
  v_rcp_f32 v13, v13
  s_nop 0
  v_mul_f32 v12, v10, v12
  v_mul_f32 v13, v11, v13
  v_cvt_pk_bf16_f32 v130, v12, v13
  v_cvt_pk_bf16_f32 v9, v118, v119
  v_lshlrev_b32 v10, 16, v9
  v_and_b32 v11, 0xffff0000, v9
  v_mul_f32 v12, 0xbfb8aa3b, v10
  v_mul_f32 v13, 0xbfb8aa3b, v11
  v_exp_f32 v12, v12
  v_exp_f32 v13, v13
  s_nop 0
  v_add_f32 v12, 1.0, v12
  v_add_f32 v13, 1.0, v13
  v_rcp_f32 v12, v12
  v_rcp_f32 v13, v13
  s_nop 0
  v_mul_f32 v12, v10, v12
  v_mul_f32 v13, v11, v13
  v_cvt_pk_bf16_f32 v131, v12, v13
  v_cvt_pk_bf16_f32 v9, v120, v121
  v_lshlrev_b32 v10, 16, v9
  v_and_b32 v11, 0xffff0000, v9
  v_mul_f32 v12, 0xbfb8aa3b, v10
  v_mul_f32 v13, 0xbfb8aa3b, v11
  v_exp_f32 v12, v12
  v_exp_f32 v13, v13
  s_nop 0
  v_add_f32 v12, 1.0, v12
  v_add_f32 v13, 1.0, v13
  v_rcp_f32 v12, v12
  v_rcp_f32 v13, v13
  s_nop 0
  v_mul_f32 v12, v10, v12
  v_mul_f32 v13, v11, v13
  v_cvt_pk_bf16_f32 v132, v12, v13
  v_cvt_pk_bf16_f32 v9, v122, v123
  v_lshlrev_b32 v10, 16, v9
  v_and_b32 v11, 0xffff0000, v9
  v_mul_f32 v12, 0xbfb8aa3b, v10
  v_mul_f32 v13, 0xbfb8aa3b, v11
  v_exp_f32 v12, v12
  v_exp_f32 v13, v13
  s_nop 0
  v_add_f32 v12, 1.0, v12
  v_add_f32 v13, 1.0, v13
  v_rcp_f32 v12, v12
  v_rcp_f32 v13, v13
  s_nop 0
  v_mul_f32 v12, v10, v12
  v_mul_f32 v13, v11, v13
  v_cvt_pk_bf16_f32 v133, v12, v13
  v_cvt_pk_bf16_f32 v9, v124, v125
  v_lshlrev_b32 v10, 16, v9
  v_and_b32 v11, 0xffff0000, v9
  v_mul_f32 v12, 0xbfb8aa3b, v10
  v_mul_f32 v13, 0xbfb8aa3b, v11
  v_exp_f32 v12, v12
  v_exp_f32 v13, v13
  s_nop 0
  v_add_f32 v12, 1.0, v12
  v_add_f32 v13, 1.0, v13
  v_rcp_f32 v12, v12
  v_rcp_f32 v13, v13
  s_nop 0
  v_mul_f32 v12, v10, v12
  v_mul_f32 v13, v11, v13
  v_cvt_pk_bf16_f32 v134, v12, v13
  v_cvt_pk_bf16_f32 v9, v126, v127
  v_lshlrev_b32 v10, 16, v9
  v_and_b32 v11, 0xffff0000, v9
  v_mul_f32 v12, 0xbfb8aa3b, v10
  v_mul_f32 v13, 0xbfb8aa3b, v11
  v_exp_f32 v12, v12
  v_exp_f32 v13, v13
  s_nop 0
  v_add_f32 v12, 1.0, v12
  v_add_f32 v13, 1.0, v13
  v_rcp_f32 v12, v12
  v_rcp_f32 v13, v13
  s_nop 0
  v_mul_f32 v12, v10, v12
  v_mul_f32 v13, v11, v13
  v_cvt_pk_bf16_f32 v135, v12, v13
  s_nop 1
  s_mov_b32 s30, 0x24000
  s_mov_b32 s31, 0x25000
  buffer_load_dwordx4 v[48:51], v8, s[16:19], s30 offen offset:0
  buffer_load_dwordx4 v[52:55], v8, s[16:19], s30 offen offset:1024
  buffer_load_dwordx4 v[56:59], v8, s[16:19], s30 offen offset:2048
  buffer_load_dwordx4 v[60:63], v8, s[16:19], s30 offen offset:3072
  buffer_load_dwordx4 v[64:67], v8, s[16:19], s31 offen offset:0
  buffer_load_dwordx4 v[68:71], v8, s[16:19], s31 offen offset:1024
  buffer_load_dwordx4 v[72:75], v8, s[16:19], s31 offen offset:2048
  buffer_load_dwordx4 v[76:79], v8, s[16:19], s31 offen offset:3072
  s_waitcnt vmcnt(8)
  v_mfma_f32_32x32x16_bf16 v[112:127], v[80:83], v[16:19], 0
  v_mfma_f32_32x32x16_bf16 v[112:127], v[84:87], v[20:23], v[112:127]
  v_mfma_f32_32x32x16_bf16 v[112:127], v[88:91], v[24:27], v[112:127]
  v_mfma_f32_32x32x16_bf16 v[112:127], v[92:95], v[28:31], v[112:127]
  v_mfma_f32_32x32x16_bf16 v[112:127], v[96:99], v[32:35], v[112:127]
  v_mfma_f32_32x32x16_bf16 v[112:127], v[100:103], v[36:39], v[112:127]
  v_mfma_f32_32x32x16_bf16 v[112:127], v[104:107], v[40:43], v[112:127]
  v_mfma_f32_32x32x16_bf16 v[112:127], v[108:111], v[44:47], v[112:127]
  s_nop 7
  s_nop 3
  v_cvt_pk_bf16_f32 v9, v112, v113
  v_lshlrev_b32 v10, 16, v9
  v_and_b32 v11, 0xffff0000, v9
  v_mul_f32 v12, 0xbfb8aa3b, v10
  v_mul_f32 v13, 0xbfb8aa3b, v11
  v_exp_f32 v12, v12
  v_exp_f32 v13, v13
  s_nop 0
  v_add_f32 v12, 1.0, v12
  v_add_f32 v13, 1.0, v13
  v_rcp_f32 v12, v12
  v_rcp_f32 v13, v13
  s_nop 0
  v_mul_f32 v12, v10, v12
  v_mul_f32 v13, v11, v13
  v_cvt_pk_bf16_f32 v136, v12, v13
  v_cvt_pk_bf16_f32 v9, v114, v115
  v_lshlrev_b32 v10, 16, v9
  v_and_b32 v11, 0xffff0000, v9
  v_mul_f32 v12, 0xbfb8aa3b, v10
  v_mul_f32 v13, 0xbfb8aa3b, v11
  v_exp_f32 v12, v12
  v_exp_f32 v13, v13
  s_nop 0
  v_add_f32 v12, 1.0, v12
  v_add_f32 v13, 1.0, v13
  v_rcp_f32 v12, v12
  v_rcp_f32 v13, v13
  s_nop 0
  v_mul_f32 v12, v10, v12
  v_mul_f32 v13, v11, v13
  v_cvt_pk_bf16_f32 v137, v12, v13
  v_cvt_pk_bf16_f32 v9, v116, v117
  v_lshlrev_b32 v10, 16, v9
  v_and_b32 v11, 0xffff0000, v9
  v_mul_f32 v12, 0xbfb8aa3b, v10
  v_mul_f32 v13, 0xbfb8aa3b, v11
  v_exp_f32 v12, v12
  v_exp_f32 v13, v13
  s_nop 0
  v_add_f32 v12, 1.0, v12
  v_add_f32 v13, 1.0, v13
  v_rcp_f32 v12, v12
  v_rcp_f32 v13, v13
  s_nop 0
  v_mul_f32 v12, v10, v12
  v_mul_f32 v13, v11, v13
  v_cvt_pk_bf16_f32 v138, v12, v13
  v_cvt_pk_bf16_f32 v9, v118, v119
  v_lshlrev_b32 v10, 16, v9
  v_and_b32 v11, 0xffff0000, v9
  v_mul_f32 v12, 0xbfb8aa3b, v10
  v_mul_f32 v13, 0xbfb8aa3b, v11
  v_exp_f32 v12, v12
  v_exp_f32 v13, v13
  s_nop 0
  v_add_f32 v12, 1.0, v12
  v_add_f32 v13, 1.0, v13
  v_rcp_f32 v12, v12
  v_rcp_f32 v13, v13
  s_nop 0
  v_mul_f32 v12, v10, v12
  v_mul_f32 v13, v11, v13
  v_cvt_pk_bf16_f32 v139, v12, v13
  v_cvt_pk_bf16_f32 v9, v120, v121
  v_lshlrev_b32 v10, 16, v9
  v_and_b32 v11, 0xffff0000, v9
  v_mul_f32 v12, 0xbfb8aa3b, v10
  v_mul_f32 v13, 0xbfb8aa3b, v11
  v_exp_f32 v12, v12
  v_exp_f32 v13, v13
  s_nop 0
  v_add_f32 v12, 1.0, v12
  v_add_f32 v13, 1.0, v13
  v_rcp_f32 v12, v12
  v_rcp_f32 v13, v13
  s_nop 0
  v_mul_f32 v12, v10, v12
  v_mul_f32 v13, v11, v13
  v_cvt_pk_bf16_f32 v140, v12, v13
  v_cvt_pk_bf16_f32 v9, v122, v123
  v_lshlrev_b32 v10, 16, v9
  v_and_b32 v11, 0xffff0000, v9
  v_mul_f32 v12, 0xbfb8aa3b, v10
  v_mul_f32 v13, 0xbfb8aa3b, v11
  v_exp_f32 v12, v12
  v_exp_f32 v13, v13
  s_nop 0
  v_add_f32 v12, 1.0, v12
  v_add_f32 v13, 1.0, v13
  v_rcp_f32 v12, v12
  v_rcp_f32 v13, v13
  s_nop 0
  v_mul_f32 v12, v10, v12
  v_mul_f32 v13, v11, v13
  v_cvt_pk_bf16_f32 v141, v12, v13
  v_cvt_pk_bf16_f32 v9, v124, v125
  v_lshlrev_b32 v10, 16, v9
  v_and_b32 v11, 0xffff0000, v9
  v_mul_f32 v12, 0xbfb8aa3b, v10
  v_mul_f32 v13, 0xbfb8aa3b, v11
  v_exp_f32 v12, v12
  v_exp_f32 v13, v13
  s_nop 0
  v_add_f32 v12, 1.0, v12
  v_add_f32 v13, 1.0, v13
  v_rcp_f32 v12, v12
  v_rcp_f32 v13, v13
  s_nop 0
  v_mul_f32 v12, v10, v12
  v_mul_f32 v13, v11, v13
  v_cvt_pk_bf16_f32 v142, v12, v13
  v_cvt_pk_bf16_f32 v9, v126, v127
  v_lshlrev_b32 v10, 16, v9
  v_and_b32 v11, 0xffff0000, v9
  v_mul_f32 v12, 0xbfb8aa3b, v10
  v_mul_f32 v13, 0xbfb8aa3b, v11
  v_exp_f32 v12, v12
  v_exp_f32 v13, v13
  s_nop 0
  v_add_f32 v12, 1.0, v12
  v_add_f32 v13, 1.0, v13
  v_rcp_f32 v12, v12
  v_rcp_f32 v13, v13
  s_nop 0
  v_mul_f32 v12, v10, v12
  v_mul_f32 v13, v11, v13
  v_cvt_pk_bf16_f32 v143, v12, v13
  s_nop 1
  s_mov_b32 s30, 0x26000
  s_mov_b32 s31, 0x27000
  buffer_load_dwordx4 v[80:83], v8, s[16:19], s30 offen offset:0
  buffer_load_dwordx4 v[84:87], v8, s[16:19], s30 offen offset:1024
  buffer_load_dwordx4 v[88:91], v8, s[16:19], s30 offen offset:2048
  buffer_load_dwordx4 v[92:95], v8, s[16:19], s30 offen offset:3072
  buffer_load_dwordx4 v[96:99], v8, s[16:19], s31 offen offset:0
  buffer_load_dwordx4 v[100:103], v8, s[16:19], s31 offen offset:1024
  buffer_load_dwordx4 v[104:107], v8, s[16:19], s31 offen offset:2048
  buffer_load_dwordx4 v[108:111], v8, s[16:19], s31 offen offset:3072
  s_waitcnt vmcnt(8)
  v_mfma_f32_32x32x16_bf16 v[112:127], v[48:51], v[16:19], 0
  v_mfma_f32_32x32x16_bf16 v[112:127], v[52:55], v[20:23], v[112:127]
  v_mfma_f32_32x32x16_bf16 v[112:127], v[56:59], v[24:27], v[112:127]
  v_mfma_f32_32x32x16_bf16 v[112:127], v[60:63], v[28:31], v[112:127]
  v_mfma_f32_32x32x16_bf16 v[112:127], v[64:67], v[32:35], v[112:127]
  v_mfma_f32_32x32x16_bf16 v[112:127], v[68:71], v[36:39], v[112:127]
  v_mfma_f32_32x32x16_bf16 v[112:127], v[72:75], v[40:43], v[112:127]
  v_mfma_f32_32x32x16_bf16 v[112:127], v[76:79], v[44:47], v[112:127]
  s_nop 7
  s_nop 3
  v_cvt_pk_bf16_f32 v9, v112, v113
  v_lshlrev_b32 v10, 16, v9
  v_and_b32 v11, 0xffff0000, v9
  v_mul_f32 v12, 0xbfb8aa3b, v10
  v_mul_f32 v13, 0xbfb8aa3b, v11
  v_exp_f32 v12, v12
  v_exp_f32 v13, v13
  s_nop 0
  v_add_f32 v12, 1.0, v12
  v_add_f32 v13, 1.0, v13
  v_rcp_f32 v12, v12
  v_rcp_f32 v13, v13
  s_nop 0
  v_mul_f32 v12, v10, v12
  v_mul_f32 v13, v11, v13
  v_cvt_pk_bf16_f32 v144, v12, v13
  v_cvt_pk_bf16_f32 v9, v114, v115
  v_lshlrev_b32 v10, 16, v9
  v_and_b32 v11, 0xffff0000, v9
  v_mul_f32 v12, 0xbfb8aa3b, v10
  v_mul_f32 v13, 0xbfb8aa3b, v11
  v_exp_f32 v12, v12
  v_exp_f32 v13, v13
  s_nop 0
  v_add_f32 v12, 1.0, v12
  v_add_f32 v13, 1.0, v13
  v_rcp_f32 v12, v12
  v_rcp_f32 v13, v13
  s_nop 0
  v_mul_f32 v12, v10, v12
  v_mul_f32 v13, v11, v13
  v_cvt_pk_bf16_f32 v145, v12, v13
  v_cvt_pk_bf16_f32 v9, v116, v117
  v_lshlrev_b32 v10, 16, v9
  v_and_b32 v11, 0xffff0000, v9
  v_mul_f32 v12, 0xbfb8aa3b, v10
  v_mul_f32 v13, 0xbfb8aa3b, v11
  v_exp_f32 v12, v12
  v_exp_f32 v13, v13
  s_nop 0
  v_add_f32 v12, 1.0, v12
  v_add_f32 v13, 1.0, v13
  v_rcp_f32 v12, v12
  v_rcp_f32 v13, v13
  s_nop 0
  v_mul_f32 v12, v10, v12
  v_mul_f32 v13, v11, v13
  v_cvt_pk_bf16_f32 v146, v12, v13
  v_cvt_pk_bf16_f32 v9, v118, v119
  v_lshlrev_b32 v10, 16, v9
  v_and_b32 v11, 0xffff0000, v9
  v_mul_f32 v12, 0xbfb8aa3b, v10
  v_mul_f32 v13, 0xbfb8aa3b, v11
  v_exp_f32 v12, v12
  v_exp_f32 v13, v13
  s_nop 0
  v_add_f32 v12, 1.0, v12
  v_add_f32 v13, 1.0, v13
  v_rcp_f32 v12, v12
  v_rcp_f32 v13, v13
  s_nop 0
  v_mul_f32 v12, v10, v12
  v_mul_f32 v13, v11, v13
  v_cvt_pk_bf16_f32 v147, v12, v13
  v_cvt_pk_bf16_f32 v9, v120, v121
  v_lshlrev_b32 v10, 16, v9
  v_and_b32 v11, 0xffff0000, v9
  v_mul_f32 v12, 0xbfb8aa3b, v10
  v_mul_f32 v13, 0xbfb8aa3b, v11
  v_exp_f32 v12, v12
  v_exp_f32 v13, v13
  s_nop 0
  v_add_f32 v12, 1.0, v12
  v_add_f32 v13, 1.0, v13
  v_rcp_f32 v12, v12
  v_rcp_f32 v13, v13
  s_nop 0
  v_mul_f32 v12, v10, v12
  v_mul_f32 v13, v11, v13
  v_cvt_pk_bf16_f32 v148, v12, v13
  v_cvt_pk_bf16_f32 v9, v122, v123
  v_lshlrev_b32 v10, 16, v9
  v_and_b32 v11, 0xffff0000, v9
  v_mul_f32 v12, 0xbfb8aa3b, v10
  v_mul_f32 v13, 0xbfb8aa3b, v11
  v_exp_f32 v12, v12
  v_exp_f32 v13, v13
  s_nop 0
  v_add_f32 v12, 1.0, v12
  v_add_f32 v13, 1.0, v13
  v_rcp_f32 v12, v12
  v_rcp_f32 v13, v13
  s_nop 0
  v_mul_f32 v12, v10, v12
  v_mul_f32 v13, v11, v13
  v_cvt_pk_bf16_f32 v149, v12, v13
  v_cvt_pk_bf16_f32 v9, v124, v125
  v_lshlrev_b32 v10, 16, v9
  v_and_b32 v11, 0xffff0000, v9
  v_mul_f32 v12, 0xbfb8aa3b, v10
  v_mul_f32 v13, 0xbfb8aa3b, v11
  v_exp_f32 v12, v12
  v_exp_f32 v13, v13
  s_nop 0
  v_add_f32 v12, 1.0, v12
  v_add_f32 v13, 1.0, v13
  v_rcp_f32 v12, v12
  v_rcp_f32 v13, v13
  s_nop 0
  v_mul_f32 v12, v10, v12
  v_mul_f32 v13, v11, v13
  v_cvt_pk_bf16_f32 v150, v12, v13
  v_cvt_pk_bf16_f32 v9, v126, v127
  v_lshlrev_b32 v10, 16, v9
  v_and_b32 v11, 0xffff0000, v9
  v_mul_f32 v12, 0xbfb8aa3b, v10
  v_mul_f32 v13, 0xbfb8aa3b, v11
  v_exp_f32 v12, v12
  v_exp_f32 v13, v13
  s_nop 0
  v_add_f32 v12, 1.0, v12
  v_add_f32 v13, 1.0, v13
  v_rcp_f32 v12, v12
  v_rcp_f32 v13, v13
  s_nop 0
  v_mul_f32 v12, v10, v12
  v_mul_f32 v13, v11, v13
  v_cvt_pk_bf16_f32 v151, v12, v13
  s_nop 1
  s_mov_b32 s30, 0x28000
  s_mov_b32 s31, 0x29000
  buffer_load_dwordx4 v[48:51], v8, s[16:19], s30 offen offset:0
  buffer_load_dwordx4 v[52:55], v8, s[16:19], s30 offen offset:1024
  buffer_load_dwordx4 v[56:59], v8, s[16:19], s30 offen offset:2048
  buffer_load_dwordx4 v[60:63], v8, s[16:19], s30 offen offset:3072
  buffer_load_dwordx4 v[64:67], v8, s[16:19], s31 offen offset:0
  buffer_load_dwordx4 v[68:71], v8, s[16:19], s31 offen offset:1024
  buffer_load_dwordx4 v[72:75], v8, s[16:19], s31 offen offset:2048
  buffer_load_dwordx4 v[76:79], v8, s[16:19], s31 offen offset:3072
  s_waitcnt vmcnt(8)
  v_mfma_f32_32x32x16_bf16 v[112:127], v[80:83], v[16:19], 0
  v_mfma_f32_32x32x16_bf16 v[112:127], v[84:87], v[20:23], v[112:127]
  v_mfma_f32_32x32x16_bf16 v[112:127], v[88:91], v[24:27], v[112:127]
  v_mfma_f32_32x32x16_bf16 v[112:127], v[92:95], v[28:31], v[112:127]
  v_mfma_f32_32x32x16_bf16 v[112:127], v[96:99], v[32:35], v[112:127]
  v_mfma_f32_32x32x16_bf16 v[112:127], v[100:103], v[36:39], v[112:127]
  v_mfma_f32_32x32x16_bf16 v[112:127], v[104:107], v[40:43], v[112:127]
  v_mfma_f32_32x32x16_bf16 v[112:127], v[108:111], v[44:47], v[112:127]
  s_nop 7
  s_nop 3
  v_cvt_pk_bf16_f32 v9, v112, v113
  v_lshlrev_b32 v10, 16, v9
  v_and_b32 v11, 0xffff0000, v9
  v_mul_f32 v12, 0xbfb8aa3b, v10
  v_mul_f32 v13, 0xbfb8aa3b, v11
  v_exp_f32 v12, v12
  v_exp_f32 v13, v13
  s_nop 0
  v_add_f32 v12, 1.0, v12
  v_add_f32 v13, 1.0, v13
  v_rcp_f32 v12, v12
  v_rcp_f32 v13, v13
  s_nop 0
  v_mul_f32 v12, v10, v12
  v_mul_f32 v13, v11, v13
  v_cvt_pk_bf16_f32 v152, v12, v13
  v_cvt_pk_bf16_f32 v9, v114, v115
  v_lshlrev_b32 v10, 16, v9
  v_and_b32 v11, 0xffff0000, v9
  v_mul_f32 v12, 0xbfb8aa3b, v10
  v_mul_f32 v13, 0xbfb8aa3b, v11
  v_exp_f32 v12, v12
  v_exp_f32 v13, v13
  s_nop 0
  v_add_f32 v12, 1.0, v12
  v_add_f32 v13, 1.0, v13
  v_rcp_f32 v12, v12
  v_rcp_f32 v13, v13
  s_nop 0
  v_mul_f32 v12, v10, v12
  v_mul_f32 v13, v11, v13
  v_cvt_pk_bf16_f32 v153, v12, v13
  v_cvt_pk_bf16_f32 v9, v116, v117
  v_lshlrev_b32 v10, 16, v9
  v_and_b32 v11, 0xffff0000, v9
  v_mul_f32 v12, 0xbfb8aa3b, v10
  v_mul_f32 v13, 0xbfb8aa3b, v11
  v_exp_f32 v12, v12
  v_exp_f32 v13, v13
  s_nop 0
  v_add_f32 v12, 1.0, v12
  v_add_f32 v13, 1.0, v13
  v_rcp_f32 v12, v12
  v_rcp_f32 v13, v13
  s_nop 0
  v_mul_f32 v12, v10, v12
  v_mul_f32 v13, v11, v13
  v_cvt_pk_bf16_f32 v154, v12, v13
  v_cvt_pk_bf16_f32 v9, v118, v119
  v_lshlrev_b32 v10, 16, v9
  v_and_b32 v11, 0xffff0000, v9
  v_mul_f32 v12, 0xbfb8aa3b, v10
  v_mul_f32 v13, 0xbfb8aa3b, v11
  v_exp_f32 v12, v12
  v_exp_f32 v13, v13
  s_nop 0
  v_add_f32 v12, 1.0, v12
  v_add_f32 v13, 1.0, v13
  v_rcp_f32 v12, v12
  v_rcp_f32 v13, v13
  s_nop 0
  v_mul_f32 v12, v10, v12
  v_mul_f32 v13, v11, v13
  v_cvt_pk_bf16_f32 v155, v12, v13
  v_cvt_pk_bf16_f32 v9, v120, v121
  v_lshlrev_b32 v10, 16, v9
  v_and_b32 v11, 0xffff0000, v9
  v_mul_f32 v12, 0xbfb8aa3b, v10
  v_mul_f32 v13, 0xbfb8aa3b, v11
  v_exp_f32 v12, v12
  v_exp_f32 v13, v13
  s_nop 0
  v_add_f32 v12, 1.0, v12
  v_add_f32 v13, 1.0, v13
  v_rcp_f32 v12, v12
  v_rcp_f32 v13, v13
  s_nop 0
  v_mul_f32 v12, v10, v12
  v_mul_f32 v13, v11, v13
  v_cvt_pk_bf16_f32 v156, v12, v13
  v_cvt_pk_bf16_f32 v9, v122, v123
  v_lshlrev_b32 v10, 16, v9
  v_and_b32 v11, 0xffff0000, v9
  v_mul_f32 v12, 0xbfb8aa3b, v10
  v_mul_f32 v13, 0xbfb8aa3b, v11
  v_exp_f32 v12, v12
  v_exp_f32 v13, v13
  s_nop 0
  v_add_f32 v12, 1.0, v12
  v_add_f32 v13, 1.0, v13
  v_rcp_f32 v12, v12
  v_rcp_f32 v13, v13
  s_nop 0
  v_mul_f32 v12, v10, v12
  v_mul_f32 v13, v11, v13
  v_cvt_pk_bf16_f32 v157, v12, v13
  v_cvt_pk_bf16_f32 v9, v124, v125
  v_lshlrev_b32 v10, 16, v9
  v_and_b32 v11, 0xffff0000, v9
  v_mul_f32 v12, 0xbfb8aa3b, v10
  v_mul_f32 v13, 0xbfb8aa3b, v11
  v_exp_f32 v12, v12
  v_exp_f32 v13, v13
  s_nop 0
  v_add_f32 v12, 1.0, v12
  v_add_f32 v13, 1.0, v13
  v_rcp_f32 v12, v12
  v_rcp_f32 v13, v13
  s_nop 0
  v_mul_f32 v12, v10, v12
  v_mul_f32 v13, v11, v13
  v_cvt_pk_bf16_f32 v158, v12, v13
  v_cvt_pk_bf16_f32 v9, v126, v127
  v_lshlrev_b32 v10, 16, v9
  v_and_b32 v11, 0xffff0000, v9
  v_mul_f32 v12, 0xbfb8aa3b, v10
  v_mul_f32 v13, 0xbfb8aa3b, v11
  v_exp_f32 v12, v12
  v_exp_f32 v13, v13
  s_nop 0
  v_add_f32 v12, 1.0, v12
  v_add_f32 v13, 1.0, v13
  v_rcp_f32 v12, v12
  v_rcp_f32 v13, v13
  s_nop 0
  v_mul_f32 v12, v10, v12
  v_mul_f32 v13, v11, v13
  v_cvt_pk_bf16_f32 v159, v12, v13
  s_nop 1
  s_mov_b32 s30, 0x2a000
  s_mov_b32 s31, 0x2b000
  buffer_load_dwordx4 v[80:83], v8, s[16:19], s30 offen offset:0
  buffer_load_dwordx4 v[84:87], v8, s[16:19], s30 offen offset:1024
  buffer_load_dwordx4 v[88:91], v8, s[16:19], s30 offen offset:2048
  buffer_load_dwordx4 v[92:95], v8, s[16:19], s30 offen offset:3072
  buffer_load_dwordx4 v[96:99], v8, s[16:19], s31 offen offset:0
  buffer_load_dwordx4 v[100:103], v8, s[16:19], s31 offen offset:1024
  buffer_load_dwordx4 v[104:107], v8, s[16:19], s31 offen offset:2048
  buffer_load_dwordx4 v[108:111], v8, s[16:19], s31 offen offset:3072
  s_waitcnt vmcnt(8)
  v_mfma_f32_32x32x16_bf16 v[112:127], v[48:51], v[128:131], 0
  v_mfma_f32_32x32x16_bf16 v[112:127], v[52:55], v[132:135], v[112:127]
  v_mfma_f32_32x32x16_bf16 v[112:127], v[56:59], v[136:139], v[112:127]
  v_mfma_f32_32x32x16_bf16 v[112:127], v[60:63], v[140:143], v[112:127]
  v_mfma_f32_32x32x16_bf16 v[112:127], v[64:67], v[144:147], v[112:127]
  v_mfma_f32_32x32x16_bf16 v[112:127], v[68:71], v[148:151], v[112:127]
  v_mfma_f32_32x32x16_bf16 v[112:127], v[72:75], v[152:155], v[112:127]
  v_mfma_f32_32x32x16_bf16 v[112:127], v[76:79], v[156:159], v[112:127]
  s_nop 7
  s_nop 3
  v_cvt_pk_bf16_f32 v10, v112, v113
  v_cvt_pk_bf16_f32 v11, v114, v115
  buffer_store_dwordx2 v[10:11], v7, s[24:27], 0 offen offset:0
  v_cvt_pk_bf16_f32 v12, v116, v117
  v_cvt_pk_bf16_f32 v13, v118, v119
  buffer_store_dwordx2 v[12:13], v7, s[24:27], 0 offen offset:16
  v_cvt_pk_bf16_f32 v10, v120, v121
  v_cvt_pk_bf16_f32 v11, v122, v123
  buffer_store_dwordx2 v[10:11], v7, s[24:27], 0 offen offset:32
  v_cvt_pk_bf16_f32 v12, v124, v125
  v_cvt_pk_bf16_f32 v13, v126, v127
  buffer_store_dwordx2 v[12:13], v7, s[24:27], 0 offen offset:48
  s_mov_b32 s30, 0x2c000
  s_mov_b32 s31, 0x2d000
  buffer_load_dwordx4 v[48:51], v8, s[16:19], s30 offen offset:0
  buffer_load_dwordx4 v[52:55], v8, s[16:19], s30 offen offset:1024
  buffer_load_dwordx4 v[56:59], v8, s[16:19], s30 offen offset:2048
  buffer_load_dwordx4 v[60:63], v8, s[16:19], s30 offen offset:3072
  buffer_load_dwordx4 v[64:67], v8, s[16:19], s31 offen offset:0
  buffer_load_dwordx4 v[68:71], v8, s[16:19], s31 offen offset:1024
  buffer_load_dwordx4 v[72:75], v8, s[16:19], s31 offen offset:2048
  buffer_load_dwordx4 v[76:79], v8, s[16:19], s31 offen offset:3072
  s_waitcnt vmcnt(8)
  v_mfma_f32_32x32x16_bf16 v[112:127], v[80:83], v[128:131], 0
  v_mfma_f32_32x32x16_bf16 v[112:127], v[84:87], v[132:135], v[112:127]
  v_mfma_f32_32x32x16_bf16 v[112:127], v[88:91], v[136:139], v[112:127]
  v_mfma_f32_32x32x16_bf16 v[112:127], v[92:95], v[140:143], v[112:127]
  v_mfma_f32_32x32x16_bf16 v[112:127], v[96:99], v[144:147], v[112:127]
  v_mfma_f32_32x32x16_bf16 v[112:127], v[100:103], v[148:151], v[112:127]
  v_mfma_f32_32x32x16_bf16 v[112:127], v[104:107], v[152:155], v[112:127]
  v_mfma_f32_32x32x16_bf16 v[112:127], v[108:111], v[156:159], v[112:127]
  s_nop 7
  s_nop 3
  v_cvt_pk_bf16_f32 v10, v112, v113
  v_cvt_pk_bf16_f32 v11, v114, v115
  buffer_store_dwordx2 v[10:11], v7, s[24:27], 0 offen offset:64
  v_cvt_pk_bf16_f32 v12, v116, v117
  v_cvt_pk_bf16_f32 v13, v118, v119
  buffer_store_dwordx2 v[12:13], v7, s[24:27], 0 offen offset:80
  v_cvt_pk_bf16_f32 v10, v120, v121
  v_cvt_pk_bf16_f32 v11, v122, v123
  buffer_store_dwordx2 v[10:11], v7, s[24:27], 0 offen offset:96
  v_cvt_pk_bf16_f32 v12, v124, v125
  v_cvt_pk_bf16_f32 v13, v126, v127
  buffer_store_dwordx2 v[12:13], v7, s[24:27], 0 offen offset:112
  s_mov_b32 s30, 0x2e000
  s_mov_b32 s31, 0x2f000
  buffer_load_dwordx4 v[80:83], v8, s[16:19], s30 offen offset:0
  buffer_load_dwordx4 v[84:87], v8, s[16:19], s30 offen offset:1024
  buffer_load_dwordx4 v[88:91], v8, s[16:19], s30 offen offset:2048
  buffer_load_dwordx4 v[92:95], v8, s[16:19], s30 offen offset:3072
  buffer_load_dwordx4 v[96:99], v8, s[16:19], s31 offen offset:0
  buffer_load_dwordx4 v[100:103], v8, s[16:19], s31 offen offset:1024
  buffer_load_dwordx4 v[104:107], v8, s[16:19], s31 offen offset:2048
  buffer_load_dwordx4 v[108:111], v8, s[16:19], s31 offen offset:3072
  s_waitcnt vmcnt(8)
  v_mfma_f32_32x32x16_bf16 v[112:127], v[48:51], v[128:131], 0
  v_mfma_f32_32x32x16_bf16 v[112:127], v[52:55], v[132:135], v[112:127]
  v_mfma_f32_32x32x16_bf16 v[112:127], v[56:59], v[136:139], v[112:127]
  v_mfma_f32_32x32x16_bf16 v[112:127], v[60:63], v[140:143], v[112:127]
  v_mfma_f32_32x32x16_bf16 v[112:127], v[64:67], v[144:147], v[112:127]
  v_mfma_f32_32x32x16_bf16 v[112:127], v[68:71], v[148:151], v[112:127]
  v_mfma_f32_32x32x16_bf16 v[112:127], v[72:75], v[152:155], v[112:127]
  v_mfma_f32_32x32x16_bf16 v[112:127], v[76:79], v[156:159], v[112:127]
  s_nop 7
  s_nop 3
  v_cvt_pk_bf16_f32 v10, v112, v113
  v_cvt_pk_bf16_f32 v11, v114, v115
  buffer_store_dwordx2 v[10:11], v7, s[24:27], 0 offen offset:128
  v_cvt_pk_bf16_f32 v12, v116, v117
  v_cvt_pk_bf16_f32 v13, v118, v119
  buffer_store_dwordx2 v[12:13], v7, s[24:27], 0 offen offset:144
  v_cvt_pk_bf16_f32 v10, v120, v121
  v_cvt_pk_bf16_f32 v11, v122, v123
  buffer_store_dwordx2 v[10:11], v7, s[24:27], 0 offen offset:160
  v_cvt_pk_bf16_f32 v12, v124, v125
  v_cvt_pk_bf16_f32 v13, v126, v127
  buffer_store_dwordx2 v[12:13], v7, s[24:27], 0 offen offset:176
  s_mov_b32 s30, 0x30000
  s_mov_b32 s31, 0x31000
  buffer_load_dwordx4 v[48:51], v8, s[16:19], s30 offen offset:0
  buffer_load_dwordx4 v[52:55], v8, s[16:19], s30 offen offset:1024
  buffer_load_dwordx4 v[56:59], v8, s[16:19], s30 offen offset:2048
  buffer_load_dwordx4 v[60:63], v8, s[16:19], s30 offen offset:3072
  buffer_load_dwordx4 v[64:67], v8, s[16:19], s31 offen offset:0
  buffer_load_dwordx4 v[68:71], v8, s[16:19], s31 offen offset:1024
  buffer_load_dwordx4 v[72:75], v8, s[16:19], s31 offen offset:2048
  buffer_load_dwordx4 v[76:79], v8, s[16:19], s31 offen offset:3072
  s_waitcnt vmcnt(8)
  v_mfma_f32_32x32x16_bf16 v[112:127], v[80:83], v[128:131], 0
  v_mfma_f32_32x32x16_bf16 v[112:127], v[84:87], v[132:135], v[112:127]
  v_mfma_f32_32x32x16_bf16 v[112:127], v[88:91], v[136:139], v[112:127]
  v_mfma_f32_32x32x16_bf16 v[112:127], v[92:95], v[140:143], v[112:127]
  v_mfma_f32_32x32x16_bf16 v[112:127], v[96:99], v[144:147], v[112:127]
  v_mfma_f32_32x32x16_bf16 v[112:127], v[100:103], v[148:151], v[112:127]
  v_mfma_f32_32x32x16_bf16 v[112:127], v[104:107], v[152:155], v[112:127]
  v_mfma_f32_32x32x16_bf16 v[112:127], v[108:111], v[156:159], v[112:127]
  s_nop 7
  s_nop 3
  v_cvt_pk_bf16_f32 v10, v112, v113
  v_cvt_pk_bf16_f32 v11, v114, v115
  buffer_store_dwordx2 v[10:11], v7, s[24:27], 0 offen offset:192
  v_cvt_pk_bf16_f32 v12, v116, v117
  v_cvt_pk_bf16_f32 v13, v118, v119
  buffer_store_dwordx2 v[12:13], v7, s[24:27], 0 offen offset:208
  v_cvt_pk_bf16_f32 v10, v120, v121
  v_cvt_pk_bf16_f32 v11, v122, v123
  buffer_store_dwordx2 v[10:11], v7, s[24:27], 0 offen offset:224
  v_cvt_pk_bf16_f32 v12, v124, v125
  v_cvt_pk_bf16_f32 v13, v126, v127
  buffer_store_dwordx2 v[12:13], v7, s[24:27], 0 offen offset:240
  s_mov_b32 s30, 0x32000
  s_mov_b32 s31, 0x33000
  buffer_load_dwordx4 v[80:83], v8, s[16:19], s30 offen offset:0
  buffer_load_dwordx4 v[84:87], v8, s[16:19], s30 offen offset:1024
  buffer_load_dwordx4 v[88:91], v8, s[16:19], s30 offen offset:2048
  buffer_load_dwordx4 v[92:95], v8, s[16:19], s30 offen offset:3072
  buffer_load_dwordx4 v[96:99], v8, s[16:19], s31 offen offset:0
  buffer_load_dwordx4 v[100:103], v8, s[16:19], s31 offen offset:1024
  buffer_load_dwordx4 v[104:107], v8, s[16:19], s31 offen offset:2048
  buffer_load_dwordx4 v[108:111], v8, s[16:19], s31 offen offset:3072
  s_waitcnt vmcnt(8)
  v_mfma_f32_32x32x16_bf16 v[112:127], v[48:51], v[128:131], 0
  v_mfma_f32_32x32x16_bf16 v[112:127], v[52:55], v[132:135], v[112:127]
  v_mfma_f32_32x32x16_bf16 v[112:127], v[56:59], v[136:139], v[112:127]
  v_mfma_f32_32x32x16_bf16 v[112:127], v[60:63], v[140:143], v[112:127]
  v_mfma_f32_32x32x16_bf16 v[112:127], v[64:67], v[144:147], v[112:127]
  v_mfma_f32_32x32x16_bf16 v[112:127], v[68:71], v[148:151], v[112:127]
  v_mfma_f32_32x32x16_bf16 v[112:127], v[72:75], v[152:155], v[112:127]
  v_mfma_f32_32x32x16_bf16 v[112:127], v[76:79], v[156:159], v[112:127]
  s_nop 7
  s_nop 3
  v_cvt_pk_bf16_f32 v10, v112, v113
  v_cvt_pk_bf16_f32 v11, v114, v115
  buffer_store_dwordx2 v[10:11], v7, s[24:27], 0 offen offset:256
  v_cvt_pk_bf16_f32 v12, v116, v117
  v_cvt_pk_bf16_f32 v13, v118, v119
  buffer_store_dwordx2 v[12:13], v7, s[24:27], 0 offen offset:272
  v_cvt_pk_bf16_f32 v10, v120, v121
  v_cvt_pk_bf16_f32 v11, v122, v123
  buffer_store_dwordx2 v[10:11], v7, s[24:27], 0 offen offset:288
  v_cvt_pk_bf16_f32 v12, v124, v125
  v_cvt_pk_bf16_f32 v13, v126, v127
  buffer_store_dwordx2 v[12:13], v7, s[24:27], 0 offen offset:304
  s_mov_b32 s30, 0x34000
  s_mov_b32 s31, 0x35000
  buffer_load_dwordx4 v[48:51], v8, s[16:19], s30 offen offset:0
  buffer_load_dwordx4 v[52:55], v8, s[16:19], s30 offen offset:1024
  buffer_load_dwordx4 v[56:59], v8, s[16:19], s30 offen offset:2048
  buffer_load_dwordx4 v[60:63], v8, s[16:19], s30 offen offset:3072
  buffer_load_dwordx4 v[64:67], v8, s[16:19], s31 offen offset:0
  buffer_load_dwordx4 v[68:71], v8, s[16:19], s31 offen offset:1024
  buffer_load_dwordx4 v[72:75], v8, s[16:19], s31 offen offset:2048
  buffer_load_dwordx4 v[76:79], v8, s[16:19], s31 offen offset:3072
  s_waitcnt vmcnt(8)
  v_mfma_f32_32x32x16_bf16 v[112:127], v[80:83], v[128:131], 0
  v_mfma_f32_32x32x16_bf16 v[112:127], v[84:87], v[132:135], v[112:127]
  v_mfma_f32_32x32x16_bf16 v[112:127], v[88:91], v[136:139], v[112:127]
  v_mfma_f32_32x32x16_bf16 v[112:127], v[92:95], v[140:143], v[112:127]
  v_mfma_f32_32x32x16_bf16 v[112:127], v[96:99], v[144:147], v[112:127]
  v_mfma_f32_32x32x16_bf16 v[112:127], v[100:103], v[148:151], v[112:127]
  v_mfma_f32_32x32x16_bf16 v[112:127], v[104:107], v[152:155], v[112:127]
  v_mfma_f32_32x32x16_bf16 v[112:127], v[108:111], v[156:159], v[112:127]
  s_nop 7
  s_nop 3
  v_cvt_pk_bf16_f32 v10, v112, v113
  v_cvt_pk_bf16_f32 v11, v114, v115
  buffer_store_dwordx2 v[10:11], v7, s[24:27], 0 offen offset:320
  v_cvt_pk_bf16_f32 v12, v116, v117
  v_cvt_pk_bf16_f32 v13, v118, v119
  buffer_store_dwordx2 v[12:13], v7, s[24:27], 0 offen offset:336
  v_cvt_pk_bf16_f32 v10, v120, v121
  v_cvt_pk_bf16_f32 v11, v122, v123
  buffer_store_dwordx2 v[10:11], v7, s[24:27], 0 offen offset:352
  v_cvt_pk_bf16_f32 v12, v124, v125
  v_cvt_pk_bf16_f32 v13, v126, v127
  buffer_store_dwordx2 v[12:13], v7, s[24:27], 0 offen offset:368
  s_mov_b32 s30, 0x36000
  s_mov_b32 s31, 0x37000
  buffer_load_dwordx4 v[80:83], v8, s[16:19], s30 offen offset:0
  buffer_load_dwordx4 v[84:87], v8, s[16:19], s30 offen offset:1024
  buffer_load_dwordx4 v[88:91], v8, s[16:19], s30 offen offset:2048
  buffer_load_dwordx4 v[92:95], v8, s[16:19], s30 offen offset:3072
  buffer_load_dwordx4 v[96:99], v8, s[16:19], s31 offen offset:0
  buffer_load_dwordx4 v[100:103], v8, s[16:19], s31 offen offset:1024
  buffer_load_dwordx4 v[104:107], v8, s[16:19], s31 offen offset:2048
  buffer_load_dwordx4 v[108:111], v8, s[16:19], s31 offen offset:3072
  s_waitcnt vmcnt(8)
  v_mfma_f32_32x32x16_bf16 v[112:127], v[48:51], v[128:131], 0
  v_mfma_f32_32x32x16_bf16 v[112:127], v[52:55], v[132:135], v[112:127]
  v_mfma_f32_32x32x16_bf16 v[112:127], v[56:59], v[136:139], v[112:127]
  v_mfma_f32_32x32x16_bf16 v[112:127], v[60:63], v[140:143], v[112:127]
  v_mfma_f32_32x32x16_bf16 v[112:127], v[64:67], v[144:147], v[112:127]
  v_mfma_f32_32x32x16_bf16 v[112:127], v[68:71], v[148:151], v[112:127]
  v_mfma_f32_32x32x16_bf16 v[112:127], v[72:75], v[152:155], v[112:127]
  v_mfma_f32_32x32x16_bf16 v[112:127], v[76:79], v[156:159], v[112:127]
  s_nop 7
  s_nop 3
  v_cvt_pk_bf16_f32 v10, v112, v113
  v_cvt_pk_bf16_f32 v11, v114, v115
  buffer_store_dwordx2 v[10:11], v7, s[24:27], 0 offen offset:384
  v_cvt_pk_bf16_f32 v12, v116, v117
  v_cvt_pk_bf16_f32 v13, v118, v119
  buffer_store_dwordx2 v[12:13], v7, s[24:27], 0 offen offset:400
  v_cvt_pk_bf16_f32 v10, v120, v121
  v_cvt_pk_bf16_f32 v11, v122, v123
  buffer_store_dwordx2 v[10:11], v7, s[24:27], 0 offen offset:416
  v_cvt_pk_bf16_f32 v12, v124, v125
  v_cvt_pk_bf16_f32 v13, v126, v127
  buffer_store_dwordx2 v[12:13], v7, s[24:27], 0 offen offset:432
  s_mov_b32 s30, 0x38000
  s_mov_b32 s31, 0x39000
  buffer_load_dwordx4 v[48:51], v8, s[16:19], s30 offen offset:0
  buffer_load_dwordx4 v[52:55], v8, s[16:19], s30 offen offset:1024
  buffer_load_dwordx4 v[56:59], v8, s[16:19], s30 offen offset:2048
  buffer_load_dwordx4 v[60:63], v8, s[16:19], s30 offen offset:3072
  buffer_load_dwordx4 v[64:67], v8, s[16:19], s31 offen offset:0
  buffer_load_dwordx4 v[68:71], v8, s[16:19], s31 offen offset:1024
  buffer_load_dwordx4 v[72:75], v8, s[16:19], s31 offen offset:2048
  buffer_load_dwordx4 v[76:79], v8, s[16:19], s31 offen offset:3072
  s_waitcnt vmcnt(8)
  v_mfma_f32_32x32x16_bf16 v[112:127], v[80:83], v[128:131], 0
  v_mfma_f32_32x32x16_bf16 v[112:127], v[84:87], v[132:135], v[112:127]
  v_mfma_f32_32x32x16_bf16 v[112:127], v[88:91], v[136:139], v[112:127]
  v_mfma_f32_32x32x16_bf16 v[112:127], v[92:95], v[140:143], v[112:127]
  v_mfma_f32_32x32x16_bf16 v[112:127], v[96:99], v[144:147], v[112:127]
  v_mfma_f32_32x32x16_bf16 v[112:127], v[100:103], v[148:151], v[112:127]
  v_mfma_f32_32x32x16_bf16 v[112:127], v[104:107], v[152:155], v[112:127]
  v_mfma_f32_32x32x16_bf16 v[112:127], v[108:111], v[156:159], v[112:127]
  s_nop 7
  s_nop 3
  v_cvt_pk_bf16_f32 v10, v112, v113
  v_cvt_pk_bf16_f32 v11, v114, v115
  buffer_store_dwordx2 v[10:11], v7, s[24:27], 0 offen offset:448
  v_cvt_pk_bf16_f32 v12, v116, v117
  v_cvt_pk_bf16_f32 v13, v118, v119
  buffer_store_dwordx2 v[12:13], v7, s[24:27], 0 offen offset:464
  v_cvt_pk_bf16_f32 v10, v120, v121
  v_cvt_pk_bf16_f32 v11, v122, v123
  buffer_store_dwordx2 v[10:11], v7, s[24:27], 0 offen offset:480
  v_cvt_pk_bf16_f32 v12, v124, v125
  v_cvt_pk_bf16_f32 v13, v126, v127
  buffer_store_dwordx2 v[12:13], v7, s[24:27], 0 offen offset:496
  s_mov_b32 s30, 0x3a000
  s_mov_b32 s31, 0x3b000
  buffer_load_dwordx4 v[80:83], v8, s[16:19], s30 offen offset:0
  buffer_load_dwordx4 v[84:87], v8, s[16:19], s30 offen offset:1024
  buffer_load_dwordx4 v[88:91], v8, s[16:19], s30 offen offset:2048
  buffer_load_dwordx4 v[92:95], v8, s[16:19], s30 offen offset:3072
  buffer_load_dwordx4 v[96:99], v8, s[16:19], s31 offen offset:0
  buffer_load_dwordx4 v[100:103], v8, s[16:19], s31 offen offset:1024
  buffer_load_dwordx4 v[104:107], v8, s[16:19], s31 offen offset:2048
  buffer_load_dwordx4 v[108:111], v8, s[16:19], s31 offen offset:3072
  s_waitcnt vmcnt(8)
  v_mfma_f32_32x32x16_bf16 v[112:127], v[48:51], v[128:131], 0
  v_mfma_f32_32x32x16_bf16 v[112:127], v[52:55], v[132:135], v[112:127]
  v_mfma_f32_32x32x16_bf16 v[112:127], v[56:59], v[136:139], v[112:127]
  v_mfma_f32_32x32x16_bf16 v[112:127], v[60:63], v[140:143], v[112:127]
  v_mfma_f32_32x32x16_bf16 v[112:127], v[64:67], v[144:147], v[112:127]
  v_mfma_f32_32x32x16_bf16 v[112:127], v[68:71], v[148:151], v[112:127]
  v_mfma_f32_32x32x16_bf16 v[112:127], v[72:75], v[152:155], v[112:127]
  v_mfma_f32_32x32x16_bf16 v[112:127], v[76:79], v[156:159], v[112:127]
  s_nop 7
  s_nop 3
  v_cvt_pk_bf16_f32 v10, v112, v113
  v_cvt_pk_bf16_f32 v11, v114, v115
  buffer_store_dwordx2 v[10:11], v7, s[24:27], 0 offen offset:512
  v_cvt_pk_bf16_f32 v12, v116, v117
  v_cvt_pk_bf16_f32 v13, v118, v119
  buffer_store_dwordx2 v[12:13], v7, s[24:27], 0 offen offset:528
  v_cvt_pk_bf16_f32 v10, v120, v121
  v_cvt_pk_bf16_f32 v11, v122, v123
  buffer_store_dwordx2 v[10:11], v7, s[24:27], 0 offen offset:544
  v_cvt_pk_bf16_f32 v12, v124, v125
  v_cvt_pk_bf16_f32 v13, v126, v127
  buffer_store_dwordx2 v[12:13], v7, s[24:27], 0 offen offset:560
  s_mov_b32 s30, 0x3c000
  s_mov_b32 s31, 0x3d000
  buffer_load_dwordx4 v[48:51], v8, s[16:19], s30 offen offset:0
  buffer_load_dwordx4 v[52:55], v8, s[16:19], s30 offen offset:1024
  buffer_load_dwordx4 v[56:59], v8, s[16:19], s30 offen offset:2048
  buffer_load_dwordx4 v[60:63], v8, s[16:19], s30 offen offset:3072
  buffer_load_dwordx4 v[64:67], v8, s[16:19], s31 offen offset:0
  buffer_load_dwordx4 v[68:71], v8, s[16:19], s31 offen offset:1024
  buffer_load_dwordx4 v[72:75], v8, s[16:19], s31 offen offset:2048
  buffer_load_dwordx4 v[76:79], v8, s[16:19], s31 offen offset:3072
  s_waitcnt vmcnt(8)
  v_mfma_f32_32x32x16_bf16 v[112:127], v[80:83], v[128:131], 0
  v_mfma_f32_32x32x16_bf16 v[112:127], v[84:87], v[132:135], v[112:127]
  v_mfma_f32_32x32x16_bf16 v[112:127], v[88:91], v[136:139], v[112:127]
  v_mfma_f32_32x32x16_bf16 v[112:127], v[92:95], v[140:143], v[112:127]
  v_mfma_f32_32x32x16_bf16 v[112:127], v[96:99], v[144:147], v[112:127]
  v_mfma_f32_32x32x16_bf16 v[112:127], v[100:103], v[148:151], v[112:127]
  v_mfma_f32_32x32x16_bf16 v[112:127], v[104:107], v[152:155], v[112:127]
  v_mfma_f32_32x32x16_bf16 v[112:127], v[108:111], v[156:159], v[112:127]
  s_nop 7
  s_nop 3
  v_cvt_pk_bf16_f32 v10, v112, v113
  v_cvt_pk_bf16_f32 v11, v114, v115
  buffer_store_dwordx2 v[10:11], v7, s[24:27], 0 offen offset:576
  v_cvt_pk_bf16_f32 v12, v116, v117
  v_cvt_pk_bf16_f32 v13, v118, v119
  buffer_store_dwordx2 v[12:13], v7, s[24:27], 0 offen offset:592
  v_cvt_pk_bf16_f32 v10, v120, v121
  v_cvt_pk_bf16_f32 v11, v122, v123
  buffer_store_dwordx2 v[10:11], v7, s[24:27], 0 offen offset:608
  v_cvt_pk_bf16_f32 v12, v124, v125
  v_cvt_pk_bf16_f32 v13, v126, v127
  buffer_store_dwordx2 v[12:13], v7, s[24:27], 0 offen offset:624
  s_mov_b32 s30, 0x3e000
  s_mov_b32 s31, 0x3f000
  buffer_load_dwordx4 v[80:83], v8, s[16:19], s30 offen offset:0
  buffer_load_dwordx4 v[84:87], v8, s[16:19], s30 offen offset:1024
  buffer_load_dwordx4 v[88:91], v8, s[16:19], s30 offen offset:2048
  buffer_load_dwordx4 v[92:95], v8, s[16:19], s30 offen offset:3072
  buffer_load_dwordx4 v[96:99], v8, s[16:19], s31 offen offset:0
  buffer_load_dwordx4 v[100:103], v8, s[16:19], s31 offen offset:1024
  buffer_load_dwordx4 v[104:107], v8, s[16:19], s31 offen offset:2048
  buffer_load_dwordx4 v[108:111], v8, s[16:19], s31 offen offset:3072
  s_waitcnt vmcnt(8)
  v_mfma_f32_32x32x16_bf16 v[112:127], v[48:51], v[128:131], 0
  v_mfma_f32_32x32x16_bf16 v[112:127], v[52:55], v[132:135], v[112:127]
  v_mfma_f32_32x32x16_bf16 v[112:127], v[56:59], v[136:139], v[112:127]
  v_mfma_f32_32x32x16_bf16 v[112:127], v[60:63], v[140:143], v[112:127]
  v_mfma_f32_32x32x16_bf16 v[112:127], v[64:67], v[144:147], v[112:127]
  v_mfma_f32_32x32x16_bf16 v[112:127], v[68:71], v[148:151], v[112:127]
  v_mfma_f32_32x32x16_bf16 v[112:127], v[72:75], v[152:155], v[112:127]
  v_mfma_f32_32x32x16_bf16 v[112:127], v[76:79], v[156:159], v[112:127]
  s_nop 7
  s_nop 3
  v_cvt_pk_bf16_f32 v10, v112, v113
  v_cvt_pk_bf16_f32 v11, v114, v115
  buffer_store_dwordx2 v[10:11], v7, s[24:27], 0 offen offset:640
  v_cvt_pk_bf16_f32 v12, v116, v117
  v_cvt_pk_bf16_f32 v13, v118, v119
  buffer_store_dwordx2 v[12:13], v7, s[24:27], 0 offen offset:656
  v_cvt_pk_bf16_f32 v10, v120, v121
  v_cvt_pk_bf16_f32 v11, v122, v123
  buffer_store_dwordx2 v[10:11], v7, s[24:27], 0 offen offset:672
  v_cvt_pk_bf16_f32 v12, v124, v125
  v_cvt_pk_bf16_f32 v13, v126, v127
  buffer_store_dwordx2 v[12:13], v7, s[24:27], 0 offen offset:688
  s_waitcnt vmcnt(0)
  v_mfma_f32_32x32x16_bf16 v[112:127], v[80:83], v[128:131], 0
  v_mfma_f32_32x32x16_bf16 v[112:127], v[84:87], v[132:135], v[112:127]
  v_mfma_f32_32x32x16_bf16 v[112:127], v[88:91], v[136:139], v[112:127]
  v_mfma_f32_32x32x16_bf16 v[112:127], v[92:95], v[140:143], v[112:127]
  v_mfma_f32_32x32x16_bf16 v[112:127], v[96:99], v[144:147], v[112:127]
  v_mfma_f32_32x32x16_bf16 v[112:127], v[100:103], v[148:151], v[112:127]
  v_mfma_f32_32x32x16_bf16 v[112:127], v[104:107], v[152:155], v[112:127]
  v_mfma_f32_32x32x16_bf16 v[112:127], v[108:111], v[156:159], v[112:127]
  s_nop 7
  s_nop 3
  v_cvt_pk_bf16_f32 v10, v112, v113
  v_cvt_pk_bf16_f32 v11, v114, v115
  buffer_store_dwordx2 v[10:11], v7, s[24:27], 0 offen offset:704
  v_cvt_pk_bf16_f32 v12, v116, v117
  v_cvt_pk_bf16_f32 v13, v118, v119
  buffer_store_dwordx2 v[12:13], v7, s[24:27], 0 offen offset:720
  v_cvt_pk_bf16_f32 v10, v120, v121
  v_cvt_pk_bf16_f32 v11, v122, v123
  buffer_store_dwordx2 v[10:11], v7, s[24:27], 0 offen offset:736
  v_cvt_pk_bf16_f32 v12, v124, v125
  v_cvt_pk_bf16_f32 v13, v126, v127
  buffer_store_dwordx2 v[12:13], v7, s[24:27], 0 offen offset:752
  s_endpgm
Le_start:
  s_waitcnt lgkmcnt(0)
  s_load_dwordx8 s[40:47], s[14:15], 0
  s_mov_b32 s16, s8
  s_mov_b32 s17, s9
  s_and_b32 s17, s17, 0xffff
  s_mov_b32 s18, 0x249f0
  s_mov_b32 s19, 0x00020000
  s_mov_b32 s20, s10
  s_mov_b32 s21, s11
  s_and_b32 s21, s21, 0xffff
  s_mov_b32 s22, 0x186a00
  s_mov_b32 s23, 0x00020000
  s_mov_b32 s24, s12
  s_mov_b32 s25, s13
  s_and_b32 s25, s25, 0xffff
  s_mov_b32 s26, 0x186a00
  s_mov_b32 s27, 0x00020000
  s_mov_b32 s28, s4
  s_mov_b32 s29, s5
  s_and_b32 s29, s29, 0xffff
  s_mov_b32 s30, 0x10000000
  s_mov_b32 s31, 0x00020000
  s_sub_u32 s3, s2, 196
  s_lshl_b32 s3, s3, 8
  v_add_u32 v1, s3, v0
  v_cmp_gt_u32 vcc, 400000, v1
  s_and_saveexec_b64 s[36:37], vcc
  s_cbranch_execz Le_end
  v_lshlrev_b32 v2, 2, v1
  buffer_load_dword v3, v2, s[20:23], 0 offen
  buffer_load_dword v4, v2, s[24:27], 0 offen
  s_waitcnt vmcnt(0)
  v_mul_u32_u24 v5, 6, v3
  v_mul_u32_u24 v6, 6, v4
  buffer_load_ushort v8, v5, s[16:19], 0 offen offset:0
  buffer_load_ushort v12, v6, s[16:19], 0 offen offset:0
  buffer_load_ushort v9, v5, s[16:19], 0 offen offset:2
  buffer_load_ushort v13, v6, s[16:19], 0 offen offset:2
  buffer_load_ushort v10, v5, s[16:19], 0 offen offset:4
  buffer_load_ushort v14, v6, s[16:19], 0 offen offset:4
  s_waitcnt vmcnt(0) lgkmcnt(0)
  v_lshlrev_b32 v8, 16, v8
  v_lshlrev_b32 v12, 16, v12
  v_sub_f32 v8, v8, v12
  v_cvt_pk_bf16_f32 v8, v8, v8
  v_lshlrev_b32 v8, 16, v8
  v_lshlrev_b32 v9, 16, v9
  v_lshlrev_b32 v13, 16, v13
  v_sub_f32 v9, v9, v13
  v_cvt_pk_bf16_f32 v9, v9, v9
  v_lshlrev_b32 v9, 16, v9
  v_lshlrev_b32 v10, 16, v10
  v_lshlrev_b32 v14, 16, v14
  v_sub_f32 v10, v10, v14
  v_cvt_pk_bf16_f32 v10, v10, v10
  v_lshlrev_b32 v10, 16, v10
  v_mul_f32 v12, v8, v8
  v_cvt_pk_bf16_f32 v12, v12, v12
  v_lshlrev_b32 v12, 16, v12
  v_mul_f32 v13, v9, v9
  v_cvt_pk_bf16_f32 v13, v13, v13
  v_lshlrev_b32 v13, 16, v13
  v_mul_f32 v14, v10, v10
  v_cvt_pk_bf16_f32 v14, v14, v14
  v_lshlrev_b32 v14, 16, v14
  v_add_f32 v12, v12, v13
  v_add_f32 v12, v12, v14
  v_cvt_pk_bf16_f32 v12, v12, v12
  v_lshlrev_b32 v12, 16, v12
  v_add_f32 v12, 0x322bcc77, v12
  v_cvt_pk_bf16_f32 v12, v12, v12
  v_lshlrev_b32 v12, 16, v12
  v_sqrt_f32 v12, v12
  s_nop 0
  v_cvt_pk_bf16_f32 v12, v12, v12
  v_lshlrev_b32 v12, 16, v12
  v_cmp_gt_f32 vcc, 0x40a00000, v12
  s_and_saveexec_b64 s[38:39], vcc
  s_cbranch_execz Le_end
  v_rcp_f32 v13, v12
  s_nop 0
  v_mul_f32 v18, v8, v13
  v_cvt_pk_bf16_f32 v18, v18, v18
  v_lshlrev_b32 v18, 16, v18
  v_mul_f32 v19, v9, v13
  v_cvt_pk_bf16_f32 v19, v19, v19
  v_lshlrev_b32 v19, 16, v19
  v_mul_f32 v20, v10, v13
  v_cvt_pk_bf16_f32 v20, v20, v20
  v_lshlrev_b32 v20, 16, v20
  v_mov_b32 v17, v3
  v_mul_f32 v21, 0x40490fdb, v12
  v_cvt_pk_bf16_f32 v21, v21, v21
  v_lshlrev_b32 v21, 16, v21
  v_mul_f32 v21, 0x3e4ccccd, v21
  v_cvt_pk_bf16_f32 v21, v21, v21
  v_lshlrev_b32 v21, 16, v21
  v_mul_f32 v21, 0.15915494, v21
  v_cos_f32 v21, v21
  s_nop 0
  v_cvt_pk_bf16_f32 v21, v21, v21
  v_lshlrev_b32 v21, 16, v21
  v_add_f32 v21, 1.0, v21
  v_cvt_pk_bf16_f32 v21, v21, v21
  v_lshlrev_b32 v21, 16, v21
  v_mul_f32 v21, 0.5, v21
  v_cvt_pk_bf16_f32 v21, v21, v21
  v_lshlrev_b32 v21, 16, v21
  v_mov_b32 v22, 0
  v_mov_b32 v23, 0
  s_lshl_b32 s48, s40, 16
  s_and_b32 s49, s40, 0xffff0000
  v_mul_f32 v32, s48, v12
  v_mul_f32 v33, s49, v12
  v_cvt_pk_bf16_f32 v32, v32, v33
  v_lshlrev_b32 v33, 16, v32
  v_and_b32 v34, 0xffff0000, v32
  v_mul_f32 v33, 0.15915494, v33
  v_mul_f32 v34, 0.15915494, v34
  v_sin_f32 v33, v33
  v_sin_f32 v34, v34
  s_nop 0
  v_cvt_pk_bf16_f32 v32, v33, v34
  v_lshlrev_b32 v33, 16, v32
  v_and_b32 v34, 0xffff0000, v32
  v_mul_f32 v33, v33, v13
  v_mul_f32 v34, v34, v13
  v_cvt_pk_bf16_f32 v24, v33, v34
  s_lshl_b32 s48, s41, 16
  s_and_b32 s49, s41, 0xffff0000
  v_mul_f32 v32, s48, v12
  v_mul_f32 v33, s49, v12
  v_cvt_pk_bf16_f32 v32, v32, v33
  v_lshlrev_b32 v33, 16, v32
  v_and_b32 v34, 0xffff0000, v32
  v_mul_f32 v33, 0.15915494, v33
  v_mul_f32 v34, 0.15915494, v34
  v_sin_f32 v33, v33
  v_sin_f32 v34, v34
  s_nop 0
  v_cvt_pk_bf16_f32 v32, v33, v34
  v_lshlrev_b32 v33, 16, v32
  v_and_b32 v34, 0xffff0000, v32
  v_mul_f32 v33, v33, v13
  v_mul_f32 v34, v34, v13
  v_cvt_pk_bf16_f32 v25, v33, v34
  s_lshl_b32 s48, s42, 16
  s_and_b32 s49, s42, 0xffff0000
  v_mul_f32 v32, s48, v12
  v_mul_f32 v33, s49, v12
  v_cvt_pk_bf16_f32 v32, v32, v33
  v_lshlrev_b32 v33, 16, v32
  v_and_b32 v34, 0xffff0000, v32
  v_mul_f32 v33, 0.15915494, v33
  v_mul_f32 v34, 0.15915494, v34
  v_sin_f32 v33, v33
  v_sin_f32 v34, v34
  s_nop 0
  v_cvt_pk_bf16_f32 v32, v33, v34
  v_lshlrev_b32 v33, 16, v32
  v_and_b32 v34, 0xffff0000, v32
  v_mul_f32 v33, v33, v13
  v_mul_f32 v34, v34, v13
  v_cvt_pk_bf16_f32 v26, v33, v34
  s_lshl_b32 s48, s43, 16
  s_and_b32 s49, s43, 0xffff0000
  v_mul_f32 v32, s48, v12
  v_mul_f32 v33, s49, v12
  v_cvt_pk_bf16_f32 v32, v32, v33
  v_lshlrev_b32 v33, 16, v32
  v_and_b32 v34, 0xffff0000, v32
  v_mul_f32 v33, 0.15915494, v33
  v_mul_f32 v34, 0.15915494, v34
  v_sin_f32 v33, v33
  v_sin_f32 v34, v34
  s_nop 0
  v_cvt_pk_bf16_f32 v32, v33, v34
  v_lshlrev_b32 v33, 16, v32
  v_and_b32 v34, 0xffff0000, v32
  v_mul_f32 v33, v33, v13
  v_mul_f32 v34, v34, v13
  v_cvt_pk_bf16_f32 v27, v33, v34
  s_lshl_b32 s48, s44, 16
  s_and_b32 s49, s44, 0xffff0000
  v_mul_f32 v32, s48, v12
  v_mul_f32 v33, s49, v12
  v_cvt_pk_bf16_f32 v32, v32, v33
  v_lshlrev_b32 v33, 16, v32
  v_and_b32 v34, 0xffff0000, v32
  v_mul_f32 v33, 0.15915494, v33
  v_mul_f32 v34, 0.15915494, v34
  v_sin_f32 v33, v33
  v_sin_f32 v34, v34
  s_nop 0
  v_cvt_pk_bf16_f32 v32, v33, v34
  v_lshlrev_b32 v33, 16, v32
  v_and_b32 v34, 0xffff0000, v32
  v_mul_f32 v33, v33, v13
  v_mul_f32 v34, v34, v13
  v_cvt_pk_bf16_f32 v28, v33, v34
  s_lshl_b32 s48, s45, 16
  s_and_b32 s49, s45, 0xffff0000
  v_mul_f32 v32, s48, v12
  v_mul_f32 v33, s49, v12
  v_cvt_pk_bf16_f32 v32, v32, v33
  v_lshlrev_b32 v33, 16, v32
  v_and_b32 v34, 0xffff0000, v32
  v_mul_f32 v33, 0.15915494, v33
  v_mul_f32 v34, 0.15915494, v34
  v_sin_f32 v33, v33
  v_sin_f32 v34, v34
  s_nop 0
  v_cvt_pk_bf16_f32 v32, v33, v34
  v_lshlrev_b32 v33, 16, v32
  v_and_b32 v34, 0xffff0000, v32
  v_mul_f32 v33, v33, v13
  v_mul_f32 v34, v34, v13
  v_cvt_pk_bf16_f32 v29, v33, v34
  s_lshl_b32 s48, s46, 16
  s_and_b32 s49, s46, 0xffff0000
  v_mul_f32 v32, s48, v12
  v_mul_f32 v33, s49, v12
  v_cvt_pk_bf16_f32 v32, v32, v33
  v_lshlrev_b32 v33, 16, v32
  v_and_b32 v34, 0xffff0000, v32
  v_mul_f32 v33, 0.15915494, v33
  v_mul_f32 v34, 0.15915494, v34
  v_sin_f32 v33, v33
  v_sin_f32 v34, v34
  s_nop 0
  v_cvt_pk_bf16_f32 v32, v33, v34
  v_lshlrev_b32 v33, 16, v32
  v_and_b32 v34, 0xffff0000, v32
  v_mul_f32 v33, v33, v13
  v_mul_f32 v34, v34, v13
  v_cvt_pk_bf16_f32 v30, v33, v34
  s_lshl_b32 s48, s47, 16
  s_and_b32 s49, s47, 0xffff0000
  v_mul_f32 v32, s48, v12
  v_mul_f32 v33, s49, v12
  v_cvt_pk_bf16_f32 v32, v32, v33
  v_lshlrev_b32 v33, 16, v32
  v_and_b32 v34, 0xffff0000, v32
  v_mul_f32 v33, 0.15915494, v33
  v_mul_f32 v34, 0.15915494, v34
  v_sin_f32 v33, v33
  v_sin_f32 v34, v34
  s_nop 0
  v_cvt_pk_bf16_f32 v32, v33, v34
  v_lshlrev_b32 v33, 16, v32
  v_and_b32 v34, 0xffff0000, v32
  v_mul_f32 v33, v33, v13
  v_mul_f32 v34, v34, v13
  v_cvt_pk_bf16_f32 v31, v33, v34
  v_lshlrev_b32 v35, 2, v4
  v_mov_b32 v16, v1
  buffer_atomic_swap v16, v35, s[28:31], 0 offen sc0
  v_lshlrev_b32 v36, 6, v1
  v_add_u32 v36, 0x2000000, v36
  buffer_store_dwordx4 v[24:27], v36, s[28:31], 0 offen offset:32
  buffer_store_dwordx4 v[28:31], v36, s[28:31], 0 offen offset:48
  s_waitcnt vmcnt(2)
  buffer_store_dwordx4 v[16:19], v36, s[28:31], 0 offen
  buffer_store_dwordx4 v[20:23], v36, s[28:31], 0 offen offset:16
Le_end:
  s_endpgm
.globl painn_agg_kernel
.p2align 8
.type painn_agg_kernel,@function
painn_agg_kernel:
  s_load_dwordx2 s[4:5], s[0:1], 80
  s_load_dwordx2 s[6:7], s[0:1], 0
  s_load_dwordx2 s[8:9], s[0:1], 64
  v_lshrrev_b32 v1, 6, v0
  v_and_b32 v2, 63, v0
  s_nop 0
  v_readfirstlane_b32 s3, v1
  s_waitcnt lgkmcnt(0)
  s_mov_b32 s12, s6
  s_mov_b32 s13, s7
  s_and_b32 s13, s13, 0xffff
  s_mov_b32 s14, 0x186a000
  s_mov_b32 s15, 0x00020000
  s_mov_b32 s16, s8
  s_mov_b32 s17, s9
  s_and_b32 s17, s17, 0xffff
  s_mov_b32 s18, 0x186a000
  s_mov_b32 s19, 0x00020000
  s_add_u32 s20, s4, 0x100000
  s_addc_u32 s21, s5, 0
  s_and_b32 s21, s21, 0xffff
  s_mov_b32 s22, 0x124f800
  s_mov_b32 s23, 0x00020000
  s_mov_b32 s24, s4
  s_mov_b32 s25, s5
  s_and_b32 s25, s25, 0xffff
  s_mov_b32 s26, 0x80000
  s_mov_b32 s27, 0x00020000
  s_add_u32 s28, s4, 0x2000000
  s_addc_u32 s29, s5, 0
  s_cmp_ge_u32 s2, 1024
  s_cbranch_scc1 La_end
  s_lshl_b32 s30, s2, 2
  s_add_u32 s30, s30, s3
  v_mul_u32_u24 v3, 192, v2
  v_lshlrev_b32 v4, 2, v2
  s_mov_b32 s31, 0x40000
  buffer_load_dwordx4 v[16:19], v3, s[24:27], s31 offen offset:0
  buffer_load_dwordx4 v[20:23], v3, s[24:27], s31 offen offset:16
  buffer_load_dwordx4 v[24:27], v3, s[24:27], s31 offen offset:32
  buffer_load_dwordx4 v[28:31], v3, s[24:27], s31 offen offset:48
  buffer_load_dwordx4 v[32:35], v3, s[24:27], s31 offen offset:64
  buffer_load_dwordx4 v[36:39], v3, s[24:27], s31 offen offset:80
  buffer_load_dwordx4 v[40:43], v3, s[24:27], s31 offen offset:96
  buffer_load_dwordx4 v[44:47], v3, s[24:27], s31 offen offset:112
  buffer_load_dwordx4 v[48:51], v3, s[24:27], s31 offen offset:128
  buffer_load_dwordx4 v[52:55], v3, s[24:27], s31 offen offset:144
  buffer_load_dwordx4 v[56:59], v3, s[24:27], s31 offen offset:160
  buffer_load_dwordx4 v[60:63], v3, s[24:27], s31 offen offset:176
  s_waitcnt vmcnt(0)
La_node:
  s_cmp_ge_u32 s30, 25000
  s_cbranch_scc1 La_end
  s_lshl_b32 s31, s30, 2
  s_load_dword s33, s[4:5], s31
  s_lshl_b32 s32, s30, 10
  buffer_load_dword v64, v4, s[12:15], s32 offen offset:0
  buffer_load_dword v65, v4, s[12:15], s32 offen offset:256
  buffer_load_dword v66, v4, s[12:15], s32 offen offset:512
  buffer_load_dword v67, v4, s[12:15], s32 offen offset:768
  v_mov_b32 v68, 0
  v_mov_b32 v69, 0
  v_mov_b32 v70, 0
  v_mov_b32 v71, 0
  v_mov_b32 v72, 0
  v_mov_b32 v73, 0
  v_mov_b32 v74, 0
  v_mov_b32 v75, 0
  s_waitcnt lgkmcnt(0)
La_edge:
  s_cmp_eq_u32 s33, -1
  s_cbranch_scc1 La_fin
  s_lshl_b32 s34, s33, 6
  s_add_u32 s36, s28, s34
  s_addc_u32 s37, s29, 0
  s_load_dwordx16 s[48:63], s[36:37], 0
  s_waitcnt lgkmcnt(0)
  s_mul_i32 s34, s49, 768
  s_lshl_b32 s35, s49, 10
  buffer_load_dword v76, v4, s[20:23], s34 offen offset:0
  buffer_load_dword v77, v4, s[20:23], s34 offen offset:256
  buffer_load_dword v78, v4, s[20:23], s34 offen offset:512
  buffer_load_dword v79, v4, s[12:15], s35 offen offset:256
  buffer_load_dword v80, v4, s[12:15], s35 offen offset:512
  buffer_load_dword v81, v4, s[12:15], s35 offen offset:768
  s_mov_b32 s33, s48
  v_dot2_f32_bf16 v82, s56, v16, 0
  v_dot2_f32_bf16 v82, s57, v17, v82
  v_dot2_f32_bf16 v82, s58, v18, v82
  v_dot2_f32_bf16 v82, s59, v19, v82
  v_dot2_f32_bf16 v82, s60, v20, v82
  v_dot2_f32_bf16 v82, s61, v21, v82
  v_dot2_f32_bf16 v82, s62, v22, v82
  v_dot2_f32_bf16 v82, s63, v23, v82
  v_dot2_f32_bf16 v83, s56, v24, 0
  v_dot2_f32_bf16 v83, s57, v25, v83
  v_dot2_f32_bf16 v83, s58, v26, v83
  v_dot2_f32_bf16 v83, s59, v27, v83
  v_dot2_f32_bf16 v83, s60, v28, v83
  v_dot2_f32_bf16 v83, s61, v29, v83
  v_dot2_f32_bf16 v83, s62, v30, v83
  v_dot2_f32_bf16 v83, s63, v31, v83
  v_dot2_f32_bf16 v84, s56, v32, 0
  v_dot2_f32_bf16 v84, s57, v33, v84
  v_dot2_f32_bf16 v84, s58, v34, v84
  v_dot2_f32_bf16 v84, s59, v35, v84
  v_dot2_f32_bf16 v84, s60, v36, v84
  v_dot2_f32_bf16 v84, s61, v37, v84
  v_dot2_f32_bf16 v84, s62, v38, v84
  v_dot2_f32_bf16 v84, s63, v39, v84
  v_dot2_f32_bf16 v85, s56, v40, 0
  v_dot2_f32_bf16 v85, s57, v41, v85
  v_dot2_f32_bf16 v85, s58, v42, v85
  v_dot2_f32_bf16 v85, s59, v43, v85
  v_dot2_f32_bf16 v85, s60, v44, v85
  v_dot2_f32_bf16 v85, s61, v45, v85
  v_dot2_f32_bf16 v85, s62, v46, v85
  v_dot2_f32_bf16 v85, s63, v47, v85
  v_dot2_f32_bf16 v86, s56, v48, 0
  v_dot2_f32_bf16 v86, s57, v49, v86
  v_dot2_f32_bf16 v86, s58, v50, v86
  v_dot2_f32_bf16 v86, s59, v51, v86
  v_dot2_f32_bf16 v86, s60, v52, v86
  v_dot2_f32_bf16 v86, s61, v53, v86
  v_dot2_f32_bf16 v86, s62, v54, v86
  v_dot2_f32_bf16 v86, s63, v55, v86
  v_dot2_f32_bf16 v87, s56, v56, 0
  v_dot2_f32_bf16 v87, s57, v57, v87
  v_dot2_f32_bf16 v87, s58, v58, v87
  v_dot2_f32_bf16 v87, s59, v59, v87
  v_dot2_f32_bf16 v87, s60, v60, v87
  v_dot2_f32_bf16 v87, s61, v61, v87
  v_dot2_f32_bf16 v87, s62, v62, v87
  v_dot2_f32_bf16 v87, s63, v63, v87
  v_mul_f32 v82, s53, v82
  v_mul_f32 v83, s53, v83
  v_mul_f32 v84, s53, v84
  v_mul_f32 v85, s53, v85
  v_mul_f32 v86, s53, v86
  v_mul_f32 v87, s53, v87
  s_waitcnt vmcnt(0)
  v_lshlrev_b32 v88, 16, v76
  v_and_b32 v89, 0xffff0000, v76
  v_lshlrev_b32 v90, 16, v77
  v_and_b32 v91, 0xffff0000, v77
  v_lshlrev_b32 v92, 16, v78
  v_and_b32 v93, 0xffff0000, v78
  v_fmac_f32 v68, v88, v82
  v_fmac_f32 v69, v89, v83
  v_mul_f32 v84, v90, v84
  v_mul_f32 v85, v91, v85
  v_mul_f32 v86, v92, v86
  v_mul_f32 v87, v93, v87
  v_lshlrev_b32 v88, 16, v79
  v_and_b32 v89, 0xffff0000, v79
  v_fmac_f32 v70, v84, v88
  v_fmac_f32 v71, v85, v89
  v_fmac_f32 v70, s50, v86
  v_fmac_f32 v71, s50, v87
  v_lshlrev_b32 v88, 16, v80
  v_and_b32 v89, 0xffff0000, v80
  v_fmac_f32 v72, v84, v88
  v_fmac_f32 v73, v85, v89
  v_fmac_f32 v72, s51, v86
  v_fmac_f32 v73, s51, v87
  v_lshlrev_b32 v88, 16, v81
  v_and_b32 v89, 0xffff0000, v81
  v_fmac_f32 v74, v84, v88
  v_fmac_f32 v75, v85, v89
  v_fmac_f32 v74, s52, v86
  v_fmac_f32 v75, s52, v87
  s_branch La_edge
La_fin:
  s_waitcnt vmcnt(0)
  v_lshlrev_b32 v88, 16, v64
  v_and_b32 v89, 0xffff0000, v64
  v_add_f32 v88, v88, v68
  v_add_f32 v89, v89, v69
  v_cvt_pk_bf16_f32 v90, v88, v89
  buffer_store_dword v90, v4, s[16:19], s32 offen offset:0
  v_lshlrev_b32 v88, 16, v65
  v_and_b32 v89, 0xffff0000, v65
  v_add_f32 v88, v88, v70
  v_add_f32 v89, v89, v71
  v_cvt_pk_bf16_f32 v91, v88, v89
  buffer_store_dword v91, v4, s[16:19], s32 offen offset:256
  v_lshlrev_b32 v88, 16, v66
  v_and_b32 v89, 0xffff0000, v66
  v_add_f32 v88, v88, v72
  v_add_f32 v89, v89, v73
  v_cvt_pk_bf16_f32 v92, v88, v89
  buffer_store_dword v92, v4, s[16:19], s32 offen offset:512
  v_lshlrev_b32 v88, 16, v67
  v_and_b32 v89, 0xffff0000, v67
  v_add_f32 v88, v88, v74
  v_add_f32 v89, v89, v75
  v_cvt_pk_bf16_f32 v93, v88, v89
  buffer_store_dword v93, v4, s[16:19], s32 offen offset:768
  s_add_u32 s30, s30, 4096
  s_branch La_node
La_end:
  s_endpgm
.section .rodata,"a"
.p2align 6
.amdhsa_kernel painn_prep_kernel
  .amdhsa_next_free_vgpr 16
  .amdhsa_next_free_sgpr 96
  .amdhsa_accum_offset 16
  .amdhsa_group_segment_fixed_size 0
  .amdhsa_kernarg_size 88
  .amdhsa_user_sgpr_count 2
  .amdhsa_user_sgpr_kernarg_segment_ptr 1
  .amdhsa_system_sgpr_workgroup_id_x 1
.end_amdhsa_kernel
.p2align 6
.amdhsa_kernel painn_mlp_edge_kernel
  .amdhsa_next_free_vgpr 160
  .amdhsa_next_free_sgpr 96
  .amdhsa_accum_offset 160
  .amdhsa_group_segment_fixed_size 0
  .amdhsa_kernarg_size 88
  .amdhsa_user_sgpr_count 2
  .amdhsa_user_sgpr_kernarg_segment_ptr 1
  .amdhsa_system_sgpr_workgroup_id_x 1
.end_amdhsa_kernel
.p2align 6
.amdhsa_kernel painn_agg_kernel
  .amdhsa_next_free_vgpr 96
  .amdhsa_next_free_sgpr 96
  .amdhsa_accum_offset 96
  .amdhsa_group_segment_fixed_size 0
  .amdhsa_kernarg_size 88
  .amdhsa_user_sgpr_count 2
  .amdhsa_user_sgpr_kernarg_segment_ptr 1
  .amdhsa_system_sgpr_workgroup_id_x 1
.end_amdhsa_kernel
```
